```python
import torch

def _softmax(x, axis=-1):
    return torch.softmax(x, dim=axis)
def _gelu(x):
    return torch.nn.functional.gelu(x, approximate="tanh")
def _silu(x):
    return torch.nn.functional.silu(x)
def _sigmoid(x):
    return torch.sigmoid(x)
def _layernorm(x, axis=-1, eps=1e-5):
    m = x.mean(dim=axis, keepdim=True)
    v = x.var(dim=axis, keepdim=True, unbiased=False)
    return (x - m) / torch.sqrt(v + eps)
def _scatter_add(tgt, idx, src, axis=0):
    return tgt.clone().index_add_(axis, idx, src)
def _segment_sum(src, seg, n):
    out = torch.zeros((n,) + src.shape[1:], dtype=src.dtype)
    return out.index_add_(0, seg, src)
def _pad(x, pw):
    flat = tuple(v for pair in reversed(pw) for v in pair)
    return torch.nn.functional.pad(x, flat)

kernel_name = 'parallel_sum__sliding_block_cached__dense_activation_silu__decode'

def setup_inputs():

    _w = (lambda a: (lambda t: t.to(torch.bfloat16) if t.is_floating_point() else t)(torch.as_tensor(a)))
    def _A_setup():
        B, Sq, D = 1, 1, 512
        Hq, Hkv, Sk, Dh = 32, 32, 8192, 128
        assert Hq % Hkv == 0, (Hq, Hkv)
        return {
            "x": _w((lambda *s: torch.randn(*s, dtype=torch.bfloat16) * 0.05)(B, Sq, D)),
            "k_cache": _w((lambda *s: torch.randn(*s, dtype=torch.bfloat16) * 3.2)(B, Hkv, Sk, Dh)),
            "v_cache": _w((lambda *s: torch.randn(*s, dtype=torch.bfloat16) * 0.8)(B, Hkv, Sk, Dh)),
            "wq": _w((lambda *s: torch.randn(*s, dtype=torch.bfloat16) * 3.2)(D, Hq * Dh) * (D ** -0.5)),
            "wo": _w((lambda *s: torch.randn(*s, dtype=torch.bfloat16) * 0.8)(Hq * Dh, D) * ((Hq * Dh) ** -0.5)),
        }
    _A_in = _A_setup()

    def _B_setup():
        B, S, D, F = 1, 1, 512, 1376
        return {
            "x": _w((lambda *s: torch.randn(*s, dtype=torch.bfloat16) * 0.05)(B, S, D)),
            "w1": _w((lambda *s: torch.randn(*s, dtype=torch.bfloat16) * 3.2)(D, F) * (D ** -0.5)),
            "w2": _w((lambda *s: torch.randn(*s, dtype=torch.bfloat16) * 0.2)(F, D) * (F ** -0.5)),
        }
    _B_in = _B_setup()

    return {
        "A_x": _A_in["x"],
        "A_k_cache": _A_in["k_cache"],
        "A_v_cache": _A_in["v_cache"],
        "A_wq": _A_in["wq"],
        "A_wo": _A_in["wo"],
        "B_x": _B_in["x"],
        "B_w1": _B_in["w1"],
        "B_w2": _B_in["w2"],
    }

def reference(A_x, A_k_cache, A_v_cache, A_wq, A_wo, B_x, B_w1, B_w2):
    def _A_ref(x, k_cache, v_cache, wq, wo):
        B, Sq, D = x.shape
        Hq, Dh = 32, 128
        Hkv, Sk = k_cache.shape[1], k_cache.shape[2]
        W = min(4096, max(256, Sk // 4))
        rep = Hq // Hkv
        q = (lambda x, *d: x.permute(*d))((x @ wq).reshape(B, Sq, Hq, Dh), 0, 2, 1, 3)
        k = (lambda x, n, axis: torch.repeat_interleave(x, n, dim=axis))(k_cache[:, :, Sk - W:, :], rep, axis=1)
        v = (lambda x, n, axis: torch.repeat_interleave(x, n, dim=axis))(v_cache[:, :, Sk - W:, :], rep, axis=1)
        scores = torch.einsum("bhqd,bhkd->bhqk", q, k) * (Dh ** -0.5)
        p = _softmax(scores, axis=-1)
        o = torch.einsum("bhqk,bhkd->bhqd", p, v)
        return (lambda x, *d: x.permute(*d))(o, 0, 2, 1, 3).reshape(B, Sq, Hq * Dh) @ wo

    def _B_ref(x, w1, w2):
        h = torch.einsum("bsd,df->bsf", x, w1)
        h = _silu(h)
        out = torch.einsum("bsf,fd->bsd", h, w2)
        return out

    x = A_x
    xn = _layernorm(x, axis=-1)
    return x + _A_ref(xn, A_k_cache, A_v_cache, A_wq, A_wo) + _B_ref(xn, B_w1, B_w2)
```

```asm
; @launch grid=(256,1,1) block=(448,1,1) lds=16384
.amdgcn_target "amdgcn-amd-amdhsa--gfx950"
.text
.globl parallel_sum__sliding_block_cached__dense_activation_silu__decode_kernel
.p2align 8
.type parallel_sum__sliding_block_cached__dense_activation_silu__decode_kernel,@function
parallel_sum__sliding_block_cached__dense_activation_silu__decode_kernel:
    s_cmp_ge_u32 s2, 256
    s_cbranch_scc1 L_end
    s_load_dwordx16 s[4:19], s[0:1], 0
    s_load_dwordx4 s[20:23], s[0:1], 64
    s_load_dwordx2 s[24:25], s[0:1], 80
    s_getpc_b64 s[84:85]
L_pc:
    v_lshlrev_b32 v8, 7, v0
    v_cmp_gt_u32 vcc, (L_end-L_pc)/128, v0
    s_and_saveexec_b64 s[74:75], vcc
    s_cbranch_execz L_pf_done
    v_mov_b32 v9, s85
    v_add_co_u32 v8, vcc, s84, v8
    s_nop 1
    v_addc_co_u32 v9, vcc, 0, v9, vcc
    global_load_dword v248, v[8:9], off
L_pf_done:
    s_mov_b64 exec, s[74:75]
    v_lshrrev_b32 v2, 6, v0
    v_and_b32 v1, 63, v0
    v_readfirstlane_b32 s26, v2
    s_and_b32 s30, s2, 7
    s_lshr_b32 s31, s2, 3
    s_lshl_b32 s27, s30, 2
    s_and_b32 s60, s31, 3
    s_add_u32 s27, s27, s60
    s_lshr_b32 s28, s2, 5
    v_and_b32 v2, 15, v1
    v_lshrrev_b32 v3, 4, v1
    v_and_b32 v4, 7, v1
    v_lshrrev_b32 v5, 3, v1
    s_mov_b32 s76, 100000
    s_cmp_ge_u32 s26, 4
    s_cbranch_scc1 L_aux
    v_lshrrev_b32 v6, 2, v2
    v_and_b32 v244, 3, v2
    v_lshlrev_b32 v6, 12, v6
    v_lshl_add_u32 v244, v3, 2, v244
    v_lshl_add_u32 v6, v244, 4, v6
    s_lshl_b32 s30, s27, 21
    s_lshl_b32 s31, s28, 16
    s_add_u32 s30, s30, s31
    s_lshl_b32 s31, s26, 10
    s_add_u32 s30, s30, s31
    s_add_u32 s86, s30, 0x180000
    s_mov_b32 s62, 16384
    s_mov_b32 s63, 32768
    s_mov_b32 s64, 49152
    v_lshlrev_b32 v7, 12, v3
    v_lshl_add_u32 v7, v2, 4, v7
    v_lshlrev_b32 v244, 4, v244
    v_add_u32 v244, 12288, v244
    v_mov_b32 v245, 12544
    s_mov_b32 s84, 0xf000f
    s_mov_b32 s85, 0xf000f
    v_cndmask_b32 v15, v245, v244, s[84:85]
    s_mov_b32 s84, 0xf000f0
    s_mov_b32 s85, 0xf000f0
    v_cndmask_b32 v16, v245, v244, s[84:85]
    s_mov_b32 s84, 0xf000f00
    s_mov_b32 s85, 0xf000f00
    v_cndmask_b32 v17, v245, v244, s[84:85]
    s_mov_b32 s84, 0xf000f000
    s_mov_b32 s85, 0xf000f000
    v_cndmask_b32 v18, v245, v244, s[84:85]
    s_mov_b32 s66, 0x22222222
    s_mov_b32 s67, 0x22222222
    s_mov_b32 s68, 0x44444444
    s_mov_b32 s69, 0x44444444
    s_mov_b32 s70, 0x88888888
    s_mov_b32 s71, 0x88888888
    s_mov_b32 s72, 0x3db504f3
    s_mov_b32 s73, 0x3fb8aa3b
    s_mov_b32 s77, 0x120000
    s_waitcnt lgkmcnt(0)
    s_add_u32 s32, s6, s86
    s_addc_u32 s33, s7, 0
    s_mov_b32 s34, 62464
    s_mov_b32 s35, 0x20000
    s_add_u32 s36, s8, s86
    s_addc_u32 s37, s9, 0
    s_mov_b32 s38, 62464
    s_mov_b32 s39, 0x20000
    s_load_dword s29, s[24:25], 0
    s_barrier
    buffer_load_dwordx4 v[28:31], v6, s[32:35], 0 offen offset:0 nt
    buffer_load_dwordx4 v[32:35], v6, s[32:35], s62 offen offset:0 nt
    buffer_load_dwordx4 v[36:39], v6, s[32:35], s63 offen offset:0 nt
    buffer_load_dwordx4 v[40:43], v6, s[32:35], s64 offen offset:0 nt
    s_lshr_b32 s80, s27, 1
    v_lshlrev_b32 v8, 12, v5
    v_lshl_add_u32 v8, v4, 4, v8
    v_lshlrev_b32 v9, 11, v5
    v_lshl_add_u32 v9, v4, 4, v9
    s_lshl_b32 s30, s27, 7
    s_lshl_b32 s31, s26, 5
    s_add_u32 s30, s30, s31
    s_lshl_b32 s30, s30, 10
    s_lshl_b32 s31, s28, 7
    s_add_u32 s30, s30, s31
    s_add_u32 s40, s12, s30
    s_addc_u32 s41, s13, 0
    s_mov_b32 s42, 31872
    s_mov_b32 s43, 0x20000
    s_mul_i32 s30, s80, 86
    s_and_b32 s31, s27, 1
    s_mul_i32 s60, s31, 44
    s_add_u32 s30, s30, s60
    s_mul_i32 s60, s26, 12
    s_add_u32 s30, s30, s60
    s_lshl_b32 s31, s31, 1
    s_sub_u32 s31, 44, s31
    s_sub_u32 s31, s31, s60
    s_min_u32 s61, s31, 12
    v_mul_u32_u24 v12, 11264, v4
    v_lshl_add_u32 v12, v5, 4, v12
    s_lshl_b32 s31, s30, 3
    s_add_u32 s31, s31, 270336
    v_add_u32 v12, s31, v12
    v_lshlrev_b32 v244, 1, v5
    v_cmp_gt_u32 s[78:79], s61, v244
    v_mov_b32 v245, 268435456
    s_nop 0
    v_cndmask_b32 v12, v245, v12, s[78:79]
    s_lshl_b32 s30, s30, 10
    s_lshl_b32 s31, s28, 7
    s_add_u32 s30, s30, s31
    s_add_u32 s44, s18, s30
    s_addc_u32 s45, s19, 0
    s_sub_u32 s61, s61, 1
    s_lshl_b32 s61, s61, 10
    s_add_u32 s46, s61, 128
    s_mov_b32 s47, 0x20000
    s_mov_b32 s48, s24
    s_mov_b32 s49, s25
    s_mov_b32 s50, 1507328
    s_mov_b32 s51, 0x20000
    s_mov_b32 s52, s4
    s_mov_b32 s53, s5
    s_mov_b32 s54, 1024
    s_mov_b32 s55, 0x20000
    s_mov_b32 s56, s20
    s_mov_b32 s57, s21
    s_mov_b32 s58, 1024
    s_mov_b32 s59, 0x20000
    s_mov_b32 s99, s80
    s_lshl_b32 s30, s28, 7
    s_lshl_b32 s31, s99, 3
    s_add_u32 s30, s30, s31
    v_and_b32 v19, 1, v1
    v_lshlrev_b32 v19, 2, v19
    v_add_u32 v19, s30, v19
    v_and_b32 v244, 1, v1
    v_lshlrev_b32 v244, 4, v244
    v_mov_b32 v245, 0xffff
    v_lshlrev_b32 v244, v244, v245
    s_mov_b32 s84, 0x3030303
    s_mov_b32 s85, 0x3030303
    v_cndmask_b32 v20, 0, v244, s[84:85]
    s_mov_b32 s84, 0xc0c0c0c
    s_mov_b32 s85, 0xc0c0c0c
    v_cndmask_b32 v21, 0, v244, s[84:85]
    s_mov_b32 s84, 0x30303030
    s_mov_b32 s85, 0x30303030
    v_cndmask_b32 v22, 0, v244, s[84:85]
    s_mov_b32 s84, 0xc0c0c0c0
    s_mov_b32 s85, 0xc0c0c0c0
    v_cndmask_b32 v23, 0, v244, s[84:85]
    s_lshl_b32 s30, s27, 13
    s_lshl_b32 s31, s26, 8
    s_add_u32 s30, s30, s31
    s_add_u32 s30, s30, 393216
    v_lshlrev_b32 v10, 10, v4
    v_lshl_add_u32 v10, v5, 5, v10
    v_add_u32 v10, s30, v10
    v_subrev_u32 v26, 389120, v10
    s_lshl_b32 s30, s27, 7
    s_add_u32 s30, s30, 655360
    v_lshlrev_b32 v11, 4, v4
    v_add_u32 v11, s30, v11
    s_lshl_b32 s30, s26, 10
    v_lshlrev_b32 v13, 4, v1
    v_add_u32 v13, s30, v13
    s_lshl_b32 s30, s26, 4
    v_lshlrev_b32 v14, 2, v3
    v_add_u32 v14, s30, v14
    s_waitcnt vmcnt(3)
    buffer_load_dwordx4 v[44:47], v6, s[32:35], 0 offen offset:256 nt
    buffer_load_dwordx4 v[48:51], v6, s[32:35], s62 offen offset:256 nt
    s_waitcnt vmcnt(4)
    buffer_load_dwordx4 v[52:55], v6, s[32:35], s63 offen offset:256 nt
    buffer_load_dwordx4 v[56:59], v6, s[32:35], s64 offen offset:256 nt
    s_waitcnt vmcnt(5)
    buffer_load_dwordx4 v[60:63], v6, s[32:35], 0 offen offset:512 nt
    buffer_load_dwordx4 v[64:67], v6, s[32:35], s62 offen offset:512 nt
    s_waitcnt vmcnt(6)
    buffer_load_dwordx4 v[68:71], v6, s[32:35], s63 offen offset:512 nt
    buffer_load_dwordx4 v[72:75], v6, s[32:35], s64 offen offset:512 nt
    s_waitcnt vmcnt(7)
    buffer_load_dwordx4 v[76:79], v6, s[32:35], 0 offen offset:768 nt
    buffer_load_dwordx4 v[80:83], v6, s[32:35], s62 offen offset:768 nt
    s_waitcnt vmcnt(8)
    buffer_load_dwordx4 v[84:87], v6, s[32:35], s63 offen offset:768 nt
    buffer_load_dwordx4 v[88:91], v6, s[32:35], s64 offen offset:768 nt
    buffer_load_dwordx4 v[220:223], v26, s[48:51], s77 offen sc1
    buffer_load_dwordx4 v[224:227], v26, s[48:51], s77 offen offset:16 sc1
    s_waitcnt vmcnt(11)
    buffer_load_dwordx4 v[92:95], v7, s[36:39], 0 offen offset:0 nt
    s_waitcnt vmcnt(11)
    buffer_load_dwordx4 v[96:99], v7, s[36:39], s62 offen offset:0 nt
    s_waitcnt vmcnt(11)
    buffer_load_dwordx4 v[100:103], v7, s[36:39], s63 offen offset:0 nt
    s_waitcnt vmcnt(11)
    buffer_load_dwordx4 v[104:107], v7, s[36:39], s64 offen offset:0 nt
    s_waitcnt vmcnt(11)
    buffer_load_dwordx4 v[108:111], v7, s[36:39], 0 offen offset:256 nt
    s_waitcnt vmcnt(11)
    buffer_load_dwordx4 v[112:115], v7, s[36:39], s62 offen offset:256 nt
    s_waitcnt vmcnt(11)
    buffer_load_dwordx4 v[116:119], v7, s[36:39], s63 offen offset:256 nt
    s_waitcnt vmcnt(11)
    buffer_load_dwordx4 v[120:123], v7, s[36:39], s64 offen offset:256 nt
    s_waitcnt vmcnt(11)
    buffer_load_dwordx4 v[124:127], v7, s[36:39], 0 offen offset:512 nt
    s_waitcnt vmcnt(11)
    buffer_load_dwordx4 v[128:131], v7, s[36:39], s62 offen offset:512 nt
    s_getreg_b32 s87, hwreg(HW_REG_XCC_ID, 0, 4)
    s_waitcnt lgkmcnt(0)
    s_add_u32 s29, s29, 0x9e3779b9
    s_and_b32 s61, s29, 0xfffffff0
    s_or_b32 s87, s87, s61
    s_waitcnt vmcnt(12)
    s_waitcnt vmcnt(10)
    v_bitop3_b32 v236, v221, v223, s87 bitop3:0x7e
    v_bitop3_b32 v237, v225, v227, s87 bitop3:0x7e
    v_or_b32 v236, v236, v237
    v_and_b32 v243, 0xfffffff0, v236
    v_cmp_ne_u32 vcc, 0, v243
    s_cbranch_vccz Lok_1
Lrt_2:
    s_sub_u32 s76, s76, 1
    buffer_load_dwordx4 v[220:223], v26, s[48:51], 0 offen sc1
    buffer_load_dwordx4 v[224:227], v26, s[48:51], 0 offen offset:16 sc1
    s_waitcnt vmcnt(0)
    v_bitop3_b32 v236, v221, v223, s87 bitop3:0x7e
    v_bitop3_b32 v237, v225, v227, s87 bitop3:0x7e
    v_or_b32 v236, v236, v237
    v_and_b32 v243, 0xfffffff0, v236
    v_cmp_ne_u32 vcc, 0, v243
    s_cbranch_vccz Lok_1
    s_sub_u32 s76, s76, 1
    buffer_load_dwordx4 v[220:223], v26, s[48:51], s77 offen sc1
    buffer_load_dwordx4 v[224:227], v26, s[48:51], s77 offen offset:16 sc1
    s_waitcnt vmcnt(0)
    v_bitop3_b32 v236, v221, v223, s87 bitop3:0x7e
    v_bitop3_b32 v237, v225, v227, s87 bitop3:0x7e
    v_or_b32 v236, v236, v237
    v_and_b32 v243, 0xfffffff0, v236
    v_cmp_ne_u32 vcc, 0, v243
    s_cbranch_vccz Lok_1
    s_cmp_gt_i32 s76, 0
    s_cbranch_scc1 Lrt_2
Lok_1:
    v_cmp_ne_u32 vcc, 0, v236
    s_cmp_eq_u64 vcc, 0
    s_cselect_b32 s91, 458752, 0
    buffer_load_dwordx4 v[132:135], v7, s[36:39], s63 offen offset:512 nt
    buffer_load_dwordx4 v[136:139], v7, s[36:39], s64 offen offset:512 nt
    buffer_load_dwordx4 v[140:143], v7, s[36:39], 0 offen offset:768 nt
    buffer_load_dwordx4 v[144:147], v7, s[36:39], s62 offen offset:768 nt
    buffer_load_dwordx4 v[148:151], v7, s[36:39], s63 offen offset:768 nt
    buffer_load_dwordx4 v[152:155], v7, s[36:39], s64 offen offset:768 nt
    v_add_f32_dpp v220, v220, v220 quad_perm:[1,0,3,2] row_mask:0xf bank_mask:0xf
    v_add_f32_dpp v222, v222, v222 quad_perm:[1,0,3,2] row_mask:0xf bank_mask:0xf
    v_add_f32_dpp v224, v224, v224 quad_perm:[1,0,3,2] row_mask:0xf bank_mask:0xf
    v_add_f32_dpp v226, v226, v226 quad_perm:[1,0,3,2] row_mask:0xf bank_mask:0xf
    v_add_f32_dpp v220, v220, v220 quad_perm:[2,3,0,1] row_mask:0xf bank_mask:0xf
    v_add_f32_dpp v222, v222, v222 quad_perm:[2,3,0,1] row_mask:0xf bank_mask:0xf
    v_add_f32_dpp v224, v224, v224 quad_perm:[2,3,0,1] row_mask:0xf bank_mask:0xf
    v_add_f32_dpp v226, v226, v226 quad_perm:[2,3,0,1] row_mask:0xf bank_mask:0xf
    v_add_f32_dpp v220, v220, v220 row_half_mirror row_mask:0xf bank_mask:0xf
    v_add_f32_dpp v222, v222, v222 row_half_mirror row_mask:0xf bank_mask:0xf
    v_add_f32_dpp v224, v224, v224 row_half_mirror row_mask:0xf bank_mask:0xf
    v_add_f32_dpp v226, v226, v226 row_half_mirror row_mask:0xf bank_mask:0xf
    v_cvt_pk_bf16_f32 v220, v220, v222
    v_cvt_pk_bf16_f32 v221, v224, v226
    s_lshl_b32 s30, s26, 6
    v_lshlrev_b32 v244, 3, v5
    v_add_u32 v244, s30, v244
    s_mov_b64 s[74:75], exec
    s_mov_b32 exec_lo, 0x01010101
    s_mov_b32 exec_hi, 0x01010101
    ds_write_b64 v244, v[220:221] offset:12288
    s_mov_b64 exec, s[74:75]
    v_add_u32 v10, s91, v10
    v_add_u32 v11, s91, v11
    s_waitcnt lgkmcnt(0)
    s_barrier
    ds_read_b128 v[180:183], v15
    ds_read_b128 v[184:187], v16
    ds_read_b128 v[188:191], v17
    ds_read_b128 v[192:195], v18
    buffer_load_dword v24, v19, s[52:55], 0 offen
    buffer_load_dwordx4 v[228:231], v12, s[48:51], 0 offen sc1
    s_waitcnt lgkmcnt(3)
    v_mfma_f32_16x16x32_bf16 v[196:199], v[28:31], v[180:183], 0
    v_mfma_f32_16x16x32_bf16 v[200:203], v[44:47], v[180:183], 0
    v_mfma_f32_16x16x32_bf16 v[204:207], v[60:63], v[180:183], 0
    v_mfma_f32_16x16x32_bf16 v[208:211], v[76:79], v[180:183], 0
    s_waitcnt lgkmcnt(2)
    v_mfma_f32_16x16x32_bf16 v[196:199], v[32:35], v[184:187], v[196:199]
    v_mfma_f32_16x16x32_bf16 v[200:203], v[48:51], v[184:187], v[200:203]
    v_mfma_f32_16x16x32_bf16 v[204:207], v[64:67], v[184:187], v[204:207]
    v_mfma_f32_16x16x32_bf16 v[208:211], v[80:83], v[184:187], v[208:211]
    s_waitcnt lgkmcnt(1)
    v_mfma_f32_16x16x32_bf16 v[196:199], v[36:39], v[188:191], v[196:199]
    v_mfma_f32_16x16x32_bf16 v[200:203], v[52:55], v[188:191], v[200:203]
    v_mfma_f32_16x16x32_bf16 v[204:207], v[68:71], v[188:191], v[204:207]
    v_mfma_f32_16x16x32_bf16 v[208:211], v[84:87], v[188:191], v[208:211]
    s_waitcnt lgkmcnt(0)
    v_mfma_f32_16x16x32_bf16 v[196:199], v[40:43], v[192:195], v[196:199]
    v_mfma_f32_16x16x32_bf16 v[200:203], v[56:59], v[192:195], v[200:203]
    v_mfma_f32_16x16x32_bf16 v[204:207], v[72:75], v[192:195], v[204:207]
    v_mfma_f32_16x16x32_bf16 v[208:211], v[88:91], v[192:195], v[208:211]
    buffer_load_dwordx4 v[156:159], v9, s[44:47], 0 offen offset:0 nt
    s_nop 3
    v_cndmask_b32 v236, v196, v197, s[66:67]
    v_cndmask_b32 v237, v200, v201, s[66:67]
    v_cndmask_b32 v238, v204, v205, s[66:67]
    v_cndmask_b32 v239, v208, v209, s[66:67]
    v_cndmask_b32 v236, v236, v198, s[68:69]
    v_cndmask_b32 v237, v237, v202, s[68:69]
    v_cndmask_b32 v238, v238, v206, s[68:69]
    v_cndmask_b32 v239, v239, v210, s[68:69]
    v_cndmask_b32 v236, v236, v199, s[70:71]
    v_cndmask_b32 v237, v237, v203, s[70:71]
    v_cndmask_b32 v238, v238, v207, s[70:71]
    v_cndmask_b32 v239, v239, v211, s[70:71]
    v_add_f32_dpp v236, v236, v236 quad_perm:[1,0,3,2] row_mask:0xf bank_mask:0xf
    v_add_f32_dpp v237, v237, v237 quad_perm:[1,0,3,2] row_mask:0xf bank_mask:0xf
    v_add_f32_dpp v238, v238, v238 quad_perm:[1,0,3,2] row_mask:0xf bank_mask:0xf
    v_add_f32_dpp v239, v239, v239 quad_perm:[1,0,3,2] row_mask:0xf bank_mask:0xf
    v_add_f32_dpp v236, v236, v236 quad_perm:[2,3,0,1] row_mask:0xf bank_mask:0xf
    v_add_f32_dpp v237, v237, v237 quad_perm:[2,3,0,1] row_mask:0xf bank_mask:0xf
    v_add_f32_dpp v238, v238, v238 quad_perm:[2,3,0,1] row_mask:0xf bank_mask:0xf
    v_add_f32_dpp v239, v239, v239 quad_perm:[2,3,0,1] row_mask:0xf bank_mask:0xf
    v_cvt_pk_bf16_f32 v244, v236, v237
    v_cvt_pk_bf16_f32 v245, v238, v239
    v_lshlrev_b32 v236, 16, v244
    v_and_b32 v237, 0xffff0000, v244
    v_lshlrev_b32 v238, 16, v245
    v_and_b32 v239, 0xffff0000, v245
    v_mul_f32 v236, s72, v236
    v_mul_f32 v237, s72, v237
    v_mul_f32 v238, s72, v238
    v_mul_f32 v239, s72, v239
    v_cvt_pk_bf16_f32 v244, v236, v237
    v_cvt_pk_bf16_f32 v245, v238, v239
    v_lshlrev_b32 v236, 16, v244
    v_and_b32 v237, 0xffff0000, v244
    v_lshlrev_b32 v238, 16, v245
    v_and_b32 v239, 0xffff0000, v245
    v_max3_f32 v244, v236, v237, v238
    v_max_f32 v244, v244, v239
    s_nop 1
    v_max_f32_dpp v244, v244, v244 row_ror:4 row_mask:0xf bank_mask:0xf
    s_nop 1
    v_max_f32_dpp v244, v244, v244 row_ror:8 row_mask:0xf bank_mask:0xf
    ds_write_b32 v14, v244 offset:12608
    buffer_load_dwordx4 v[160:163], v9, s[44:47], 0 offen offset:1024 nt
    v_mov_b32 v245, 0
    s_waitcnt lgkmcnt(0)
    s_barrier
    ds_read_b128 v[196:199], v245 offset:12608
    ds_read_b128 v[200:203], v245 offset:12624
    ds_read_b128 v[204:207], v245 offset:12640
    ds_read_b128 v[208:211], v245 offset:12656
    s_waitcnt lgkmcnt(0)
    v_max3_f32 v196, v196, v197, v198
    v_max3_f32 v199, v199, v200, v201
    v_max3_f32 v202, v202, v203, v204
    v_max3_f32 v205, v205, v206, v207
    v_max3_f32 v208, v208, v209, v210
    v_max3_f32 v196, v196, v199, v202
    v_max3_f32 v205, v205, v208, v211
    v_max_f32 v25, v196, v205
    v_sub_f32 v236, v236, v25
    v_sub_f32 v237, v237, v25
    v_sub_f32 v238, v238, v25
    v_sub_f32 v239, v239, v25
    v_mul_f32 v236, s73, v236
    v_mul_f32 v237, s73, v237
    v_mul_f32 v238, s73, v238
    v_mul_f32 v239, s73, v239
    v_exp_f32 v236, v236
    v_exp_f32 v237, v237
    v_exp_f32 v238, v238
    v_exp_f32 v239, v239
    v_cvt_pk_bf16_f32 v232, v236, v236
    v_cvt_pk_bf16_f32 v233, v237, v237
    v_cvt_pk_bf16_f32 v234, v238, v238
    v_cvt_pk_bf16_f32 v235, v239, v239
    v_add_f32 v244, v236, v237
    v_add_f32 v245, v238, v239
    v_add_f32 v244, v244, v245
    v_and_b32_dpp v212, v232, v20 row_newbcast:0 row_mask:0xf bank_mask:0xf
    v_and_b32_dpp v213, v232, v21 row_newbcast:0 row_mask:0xf bank_mask:0xf
    v_and_b32_dpp v214, v232, v22 row_newbcast:0 row_mask:0xf bank_mask:0xf
    v_and_b32_dpp v215, v232, v23 row_newbcast:0 row_mask:0xf bank_mask:0xf
    v_add_f32_dpp v244, v244, v244 row_ror:4 row_mask:0xf bank_mask:0xf
    s_nop 1
    v_add_f32_dpp v244, v244, v244 row_ror:8 row_mask:0xf bank_mask:0xf
    ds_write_b32 v14, v244 offset:12672
    v_mov_b32 v245, 0
    ds_write_b32 v245, v25 offset:12564
    v_and_b32_dpp v216, v232, v20 row_newbcast:4 row_mask:0xf bank_mask:0xf
    v_and_b32_dpp v217, v232, v21 row_newbcast:4 row_mask:0xf bank_mask:0xf
    v_and_b32_dpp v218, v232, v22 row_newbcast:4 row_mask:0xf bank_mask:0xf
    v_and_b32_dpp v219, v232, v23 row_newbcast:4 row_mask:0xf bank_mask:0xf
    s_waitcnt vmcnt(19)
    v_mfma_f32_16x16x32_bf16 v[200:203], v[92:95], v[212:215], 0
    buffer_load_dwordx4 v[164:167], v8, s[40:43], 0 offen offset:0 nt
    buffer_load_dwordx4 v[168:171], v8, s[40:43], 0 offen offset:1024 nt
    buffer_load_dwordx4 v[172:175], v8, s[40:43], 0 offen offset:2048 nt
    v_and_b32_dpp v212, v232, v20 row_newbcast:8 row_mask:0xf bank_mask:0xf
    v_and_b32_dpp v213, v232, v21 row_newbcast:8 row_mask:0xf bank_mask:0xf
    v_and_b32_dpp v214, v232, v22 row_newbcast:8 row_mask:0xf bank_mask:0xf
    v_and_b32_dpp v215, v232, v23 row_newbcast:8 row_mask:0xf bank_mask:0xf
    s_waitcnt vmcnt(21)
    v_mfma_f32_16x16x32_bf16 v[200:203], v[96:99], v[216:219], v[200:203]
    buffer_load_dwordx4 v[176:179], v8, s[40:43], 0 offen offset:3072 nt
    v_and_b32_dpp v216, v232, v20 row_newbcast:12 row_mask:0xf bank_mask:0xf
    v_and_b32_dpp v217, v232, v21 row_newbcast:12 row_mask:0xf bank_mask:0xf
    v_and_b32_dpp v218, v232, v22 row_newbcast:12 row_mask:0xf bank_mask:0xf
    v_and_b32_dpp v219, v232, v23 row_newbcast:12 row_mask:0xf bank_mask:0xf
    s_waitcnt vmcnt(21)
    v_mfma_f32_16x16x32_bf16 v[200:203], v[100:103], v[212:215], v[200:203]
    v_and_b32_dpp v212, v233, v20 row_newbcast:0 row_mask:0xf bank_mask:0xf
    v_and_b32_dpp v213, v233, v21 row_newbcast:0 row_mask:0xf bank_mask:0xf
    v_and_b32_dpp v214, v233, v22 row_newbcast:0 row_mask:0xf bank_mask:0xf
    v_and_b32_dpp v215, v233, v23 row_newbcast:0 row_mask:0xf bank_mask:0xf
    s_waitcnt vmcnt(20)
    v_mfma_f32_16x16x32_bf16 v[200:203], v[104:107], v[216:219], v[200:203]
    v_and_b32_dpp v216, v233, v20 row_newbcast:4 row_mask:0xf bank_mask:0xf
    v_and_b32_dpp v217, v233, v21 row_newbcast:4 row_mask:0xf bank_mask:0xf
    v_and_b32_dpp v218, v233, v22 row_newbcast:4 row_mask:0xf bank_mask:0xf
    v_and_b32_dpp v219, v233, v23 row_newbcast:4 row_mask:0xf bank_mask:0xf
    s_waitcnt vmcnt(19)
    v_mfma_f32_16x16x32_bf16 v[200:203], v[108:111], v[212:215], v[200:203]
    v_and_b32_dpp v212, v233, v20 row_newbcast:8 row_mask:0xf bank_mask:0xf
    v_and_b32_dpp v213, v233, v21 row_newbcast:8 row_mask:0xf bank_mask:0xf
    v_and_b32_dpp v214, v233, v22 row_newbcast:8 row_mask:0xf bank_mask:0xf
    v_and_b32_dpp v215, v233, v23 row_newbcast:8 row_mask:0xf bank_mask:0xf
    s_waitcnt vmcnt(18)
    v_mfma_f32_16x16x32_bf16 v[200:203], v[112:115], v[216:219], v[200:203]
    v_and_b32_dpp v216, v233, v20 row_newbcast:12 row_mask:0xf bank_mask:0xf
    v_and_b32_dpp v217, v233, v21 row_newbcast:12 row_mask:0xf bank_mask:0xf
    v_and_b32_dpp v218, v233, v22 row_newbcast:12 row_mask:0xf bank_mask:0xf
    v_and_b32_dpp v219, v233, v23 row_newbcast:12 row_mask:0xf bank_mask:0xf
    s_waitcnt vmcnt(17)
    v_mfma_f32_16x16x32_bf16 v[200:203], v[116:119], v[212:215], v[200:203]
    v_and_b32_dpp v212, v234, v20 row_newbcast:0 row_mask:0xf bank_mask:0xf
    v_and_b32_dpp v213, v234, v21 row_newbcast:0 row_mask:0xf bank_mask:0xf
    v_and_b32_dpp v214, v234, v22 row_newbcast:0 row_mask:0xf bank_mask:0xf
    v_and_b32_dpp v215, v234, v23 row_newbcast:0 row_mask:0xf bank_mask:0xf
    s_waitcnt vmcnt(16)
    v_mfma_f32_16x16x32_bf16 v[200:203], v[120:123], v[216:219], v[200:203]
    v_and_b32_dpp v216, v234, v20 row_newbcast:4 row_mask:0xf bank_mask:0xf
    v_and_b32_dpp v217, v234, v21 row_newbcast:4 row_mask:0xf bank_mask:0xf
    v_and_b32_dpp v218, v234, v22 row_newbcast:4 row_mask:0xf bank_mask:0xf
    v_and_b32_dpp v219, v234, v23 row_newbcast:4 row_mask:0xf bank_mask:0xf
    s_waitcnt vmcnt(15)
    v_mfma_f32_16x16x32_bf16 v[200:203], v[124:127], v[212:215], v[200:203]
    v_and_b32_dpp v212, v234, v20 row_newbcast:8 row_mask:0xf bank_mask:0xf
    v_and_b32_dpp v213, v234, v21 row_newbcast:8 row_mask:0xf bank_mask:0xf
    v_and_b32_dpp v214, v234, v22 row_newbcast:8 row_mask:0xf bank_mask:0xf
    v_and_b32_dpp v215, v234, v23 row_newbcast:8 row_mask:0xf bank_mask:0xf
    s_waitcnt vmcnt(14)
    v_mfma_f32_16x16x32_bf16 v[200:203], v[128:131], v[216:219], v[200:203]
    v_and_b32_dpp v216, v234, v20 row_newbcast:12 row_mask:0xf bank_mask:0xf
    v_and_b32_dpp v217, v234, v21 row_newbcast:12 row_mask:0xf bank_mask:0xf
    v_and_b32_dpp v218, v234, v22 row_newbcast:12 row_mask:0xf bank_mask:0xf
    v_and_b32_dpp v219, v234, v23 row_newbcast:12 row_mask:0xf bank_mask:0xf
    s_waitcnt vmcnt(13)
    v_mfma_f32_16x16x32_bf16 v[200:203], v[132:135], v[212:215], v[200:203]
    v_and_b32_dpp v212, v235, v20 row_newbcast:0 row_mask:0xf bank_mask:0xf
    v_and_b32_dpp v213, v235, v21 row_newbcast:0 row_mask:0xf bank_mask:0xf
    v_and_b32_dpp v214, v235, v22 row_newbcast:0 row_mask:0xf bank_mask:0xf
    v_and_b32_dpp v215, v235, v23 row_newbcast:0 row_mask:0xf bank_mask:0xf
    s_waitcnt vmcnt(12)
    v_mfma_f32_16x16x32_bf16 v[200:203], v[136:139], v[216:219], v[200:203]
    v_and_b32_dpp v216, v235, v20 row_newbcast:4 row_mask:0xf bank_mask:0xf
    v_and_b32_dpp v217, v235, v21 row_newbcast:4 row_mask:0xf bank_mask:0xf
    v_and_b32_dpp v218, v235, v22 row_newbcast:4 row_mask:0xf bank_mask:0xf
    v_and_b32_dpp v219, v235, v23 row_newbcast:4 row_mask:0xf bank_mask:0xf
    s_waitcnt vmcnt(11)
    v_mfma_f32_16x16x32_bf16 v[200:203], v[140:143], v[212:215], v[200:203]
    v_and_b32_dpp v212, v235, v20 row_newbcast:8 row_mask:0xf bank_mask:0xf
    v_and_b32_dpp v213, v235, v21 row_newbcast:8 row_mask:0xf bank_mask:0xf
    v_and_b32_dpp v214, v235, v22 row_newbcast:8 row_mask:0xf bank_mask:0xf
    v_and_b32_dpp v215, v235, v23 row_newbcast:8 row_mask:0xf bank_mask:0xf
    s_waitcnt vmcnt(10)
    v_mfma_f32_16x16x32_bf16 v[200:203], v[144:147], v[216:219], v[200:203]
    v_and_b32_dpp v216, v235, v20 row_newbcast:12 row_mask:0xf bank_mask:0xf
    v_and_b32_dpp v217, v235, v21 row_newbcast:12 row_mask:0xf bank_mask:0xf
    v_and_b32_dpp v218, v235, v22 row_newbcast:12 row_mask:0xf bank_mask:0xf
    v_and_b32_dpp v219, v235, v23 row_newbcast:12 row_mask:0xf bank_mask:0xf
    s_waitcnt vmcnt(9)
    v_mfma_f32_16x16x32_bf16 v[200:203], v[148:151], v[212:215], v[200:203]
    s_waitcnt vmcnt(8)
    v_mfma_f32_16x16x32_bf16 v[200:203], v[152:155], v[216:219], v[200:203]
    s_nop 7
    ds_write_b128 v13, v[200:203] offset:0
    s_waitcnt lgkmcnt(0)
    s_barrier
    s_waitcnt vmcnt(6)
    v_bitop3_b32 v236, v229, v231, s29 bitop3:0x7e
    v_cmp_ne_u32 vcc, 0, v236
    s_and_b64 vcc, vcc, s[78:79]
    s_cbranch_vccz Lok_3
Lrt_4:
    s_sub_u32 s76, s76, 1
    buffer_load_dwordx4 v[228:231], v12, s[48:51], 0 offen sc1
    s_waitcnt vmcnt(0)
    v_bitop3_b32 v236, v229, v231, s29 bitop3:0x7e
    v_cmp_ne_u32 vcc, 0, v236
    s_and_b64 vcc, vcc, s[78:79]
    s_cbranch_vccz Lok_3
    s_cmp_gt_i32 s76, 0
    s_cbranch_scc1 Lrt_4
Lok_3:
    v_add_f32_dpp v228, v228, v228 quad_perm:[1,0,3,2] row_mask:0xf bank_mask:0xf
    v_add_f32_dpp v230, v230, v230 quad_perm:[1,0,3,2] row_mask:0xf bank_mask:0xf
    s_nop 0
    v_add_f32_dpp v228, v228, v228 quad_perm:[2,3,0,1] row_mask:0xf bank_mask:0xf
    v_add_f32_dpp v230, v230, v230 quad_perm:[2,3,0,1] row_mask:0xf bank_mask:0xf
    s_nop 0
    v_add_f32_dpp v228, v228, v228 row_half_mirror row_mask:0xf bank_mask:0xf
    v_add_f32_dpp v230, v230, v230 row_half_mirror row_mask:0xf bank_mask:0xf
    v_cvt_pk_bf16_f32 v244, v228, v230
    v_lshlrev_b32 v228, 16, v244
    v_and_b32 v230, 0xffff0000, v244
    v_mul_f32 v236, s73, v228
    v_mul_f32 v237, s73, v230
    v_exp_f32 v236, -v236
    v_exp_f32 v237, -v237
    v_add_f32 v236, 1.0, v236
    v_add_f32 v237, 1.0, v237
    v_rcp_f32 v236, v236
    v_rcp_f32 v237, v237
    v_mul_f32 v228, v228, v236
    v_mul_f32 v230, v230, v237
    v_cvt_pk_bf16_f32 v228, v228, v228
    v_cvt_pk_bf16_f32 v230, v230, v230
    v_cndmask_b32 v228, 0, v228, s[78:79]
    v_cndmask_b32 v230, 0, v230, s[78:79]
    v_and_b32 v212, v228, v20
    v_and_b32 v213, v228, v21
    v_and_b32 v214, v228, v22
    v_and_b32 v215, v228, v23
    v_and_b32 v216, v230, v20
    v_and_b32 v217, v230, v21
    v_and_b32 v218, v230, v22
    v_and_b32 v219, v230, v23
    s_waitcnt vmcnt(5)
    v_mfma_f32_16x16x32_bf16 v[204:207], v[156:159], v[212:215], 0
    s_waitcnt vmcnt(4)
    v_mfma_f32_16x16x32_bf16 v[204:207], v[160:163], v[216:219], v[204:207]
    buffer_load_dwordx4 v[220:223], v10, s[48:51], 0 offen sc1
    buffer_load_dwordx4 v[224:227], v10, s[48:51], 0 offen offset:16 sc1
    buffer_load_dwordx4 v[228:231], v11, s[48:51], 0 offen sc1
    s_waitcnt vmcnt(0)
    v_bitop3_b32 v236, v221, v223, s29 bitop3:0x7e
    v_bitop3_b32 v237, v225, v227, s29 bitop3:0x7e
    v_bitop3_b32 v238, v229, v231, s29 bitop3:0x7e
    v_or3_b32 v236, v236, v237, v238
    v_cmp_ne_u32 vcc, 0, v236
    s_cbranch_vccz Lok_5
Lrt_6:
    s_sub_u32 s76, s76, 1
    buffer_load_dwordx4 v[220:223], v10, s[48:51], 0 offen sc1
    buffer_load_dwordx4 v[224:227], v10, s[48:51], 0 offen offset:16 sc1
    buffer_load_dwordx4 v[228:231], v11, s[48:51], 0 offen sc1
    s_waitcnt vmcnt(0)
    v_bitop3_b32 v236, v221, v223, s29 bitop3:0x7e
    v_bitop3_b32 v237, v225, v227, s29 bitop3:0x7e
    v_bitop3_b32 v238, v229, v231, s29 bitop3:0x7e
    v_or3_b32 v236, v236, v237, v238
    v_cmp_ne_u32 vcc, 0, v236
    s_cbranch_vccz Lok_5
    s_cmp_gt_i32 s76, 0
    s_cbranch_scc1 Lrt_6
Lok_5:
    v_mov_b32 v244, v228
    s_nop 1
    v_max_f32_dpp v244, v244, v244 quad_perm:[1,0,3,2] row_mask:0xf bank_mask:0xf
    s_nop 1
    v_max_f32_dpp v244, v244, v244 quad_perm:[2,3,0,1] row_mask:0xf bank_mask:0xf
    s_nop 1
    v_max_f32_dpp v244, v244, v244 row_half_mirror row_mask:0xf bank_mask:0xf
    v_sub_f32 v244, v228, v244
    v_mul_f32 v244, s73, v244
    v_exp_f32 v244, v244
    s_nop 0
    v_mul_f32 v230, v230, v244
    v_mul_f32 v220, v220, v244
    v_mul_f32 v222, v222, v244
    v_mul_f32 v224, v224, v244
    v_mul_f32 v226, v226, v244
    v_add_f32_dpp v230, v230, v230 quad_perm:[1,0,3,2] row_mask:0xf bank_mask:0xf
    v_add_f32_dpp v220, v220, v220 quad_perm:[1,0,3,2] row_mask:0xf bank_mask:0xf
    v_add_f32_dpp v222, v222, v222 quad_perm:[1,0,3,2] row_mask:0xf bank_mask:0xf
    v_add_f32_dpp v224, v224, v224 quad_perm:[1,0,3,2] row_mask:0xf bank_mask:0xf
    v_add_f32_dpp v226, v226, v226 quad_perm:[1,0,3,2] row_mask:0xf bank_mask:0xf
    v_add_f32_dpp v230, v230, v230 quad_perm:[2,3,0,1] row_mask:0xf bank_mask:0xf
    v_add_f32_dpp v220, v220, v220 quad_perm:[2,3,0,1] row_mask:0xf bank_mask:0xf
    v_add_f32_dpp v222, v222, v222 quad_perm:[2,3,0,1] row_mask:0xf bank_mask:0xf
    v_add_f32_dpp v224, v224, v224 quad_perm:[2,3,0,1] row_mask:0xf bank_mask:0xf
    v_add_f32_dpp v226, v226, v226 quad_perm:[2,3,0,1] row_mask:0xf bank_mask:0xf
    v_add_f32_dpp v230, v230, v230 row_half_mirror row_mask:0xf bank_mask:0xf
    v_add_f32_dpp v220, v220, v220 row_half_mirror row_mask:0xf bank_mask:0xf
    v_add_f32_dpp v222, v222, v222 row_half_mirror row_mask:0xf bank_mask:0xf
    v_add_f32_dpp v224, v224, v224 row_half_mirror row_mask:0xf bank_mask:0xf
    v_add_f32_dpp v226, v226, v226 row_half_mirror row_mask:0xf bank_mask:0xf
    v_rcp_f32 v230, v230
    s_nop 0
    v_mul_f32 v220, v220, v230
    v_mul_f32 v222, v222, v230
    v_mul_f32 v224, v224, v230
    v_mul_f32 v226, v226, v230
    v_cvt_pk_bf16_f32 v220, v220, v220
    v_cvt_pk_bf16_f32 v222, v222, v222
    v_cvt_pk_bf16_f32 v224, v224, v224
    v_cvt_pk_bf16_f32 v226, v226, v226
    v_and_b32 v212, v220, v20
    v_and_b32 v213, v220, v21
    v_and_b32 v214, v220, v22
    v_and_b32 v215, v220, v23
    v_and_b32 v216, v222, v20
    v_and_b32 v217, v222, v21
    v_and_b32 v218, v222, v22
    v_and_b32 v219, v222, v23
    v_mfma_f32_16x16x32_bf16 v[204:207], v[164:167], v[212:215], v[204:207]
    v_and_b32 v212, v224, v20
    v_and_b32 v213, v224, v21
    v_and_b32 v214, v224, v22
    v_and_b32 v215, v224, v23
    v_mfma_f32_16x16x32_bf16 v[204:207], v[168:171], v[216:219], v[204:207]
    v_and_b32 v216, v226, v20
    v_and_b32 v217, v226, v21
    v_and_b32 v218, v226, v22
    v_and_b32 v219, v226, v23
    v_mfma_f32_16x16x32_bf16 v[204:207], v[172:175], v[212:215], v[204:207]
    s_nop 0
    v_mfma_f32_16x16x32_bf16 v[204:207], v[176:179], v[216:219], v[204:207]
    s_lshl_b32 s30, s28, 14
    s_lshl_b32 s31, s99, 5
    s_add_u32 s30, s30, s31
    s_add_u32 s30, s30, 720896
    v_lshrrev_b32 v244, 1, v1
    v_lshlrev_b32 v244, 9, v244
    v_and_b32 v245, 1, v1
    v_lshl_add_u32 v244, v245, 4, v244
    v_add_u32 v10, s30, v244
    ds_write_b128 v13, v[204:207] offset:4096
    s_waitcnt lgkmcnt(0)
    s_barrier
    s_and_b32 s30, s27, 1
    s_or_b32 s30, s30, s26
    s_cmp_eq_u32 s30, 0
    s_cbranch_scc0 L_main_fin
    buffer_load_dwordx4 v[220:223], v10, s[48:51], 0 offen sc1
    v_lshlrev_b32 v246, 16, v24
    v_and_b32 v247, 0xffff0000, v24
    s_waitcnt vmcnt(0)
    v_bitop3_b32 v236, v221, v223, s29 bitop3:0x7e
    v_cmp_ne_u32 vcc, 0, v236
    s_cbranch_vccz Lok_7
Lrt_8:
    s_sub_u32 s76, s76, 1
    buffer_load_dwordx4 v[220:223], v10, s[48:51], 0 offen sc1
    s_waitcnt vmcnt(0)
    v_bitop3_b32 v236, v221, v223, s29 bitop3:0x7e
    v_cmp_ne_u32 vcc, 0, v236
    s_cbranch_vccz Lok_7
    s_cmp_gt_i32 s76, 0
    s_cbranch_scc1 Lrt_8
Lok_7:
    v_add_f32_dpp v220, v220, v220 quad_perm:[2,3,0,1] row_mask:0xf bank_mask:0xf
    v_add_f32_dpp v222, v222, v222 quad_perm:[2,3,0,1] row_mask:0xf bank_mask:0xf
    s_nop 0
    v_add_f32_dpp v220, v220, v220 row_ror:4 row_mask:0xf bank_mask:0xf
    v_add_f32_dpp v222, v222, v222 row_ror:4 row_mask:0xf bank_mask:0xf
    s_nop 0
    v_add_f32_dpp v220, v220, v220 row_ror:8 row_mask:0xf bank_mask:0xf
    v_add_f32_dpp v222, v222, v222 row_ror:8 row_mask:0xf bank_mask:0xf
    v_mov_b32 v236, v220
    v_mov_b32 v237, v222
    s_nop 0
    v_permlane16_swap_b32 v220, v236
    v_permlane16_swap_b32 v222, v237
    v_add_f32 v220, v220, v236
    v_add_f32 v222, v222, v237
    v_mov_b32 v236, v220
    v_mov_b32 v237, v222
    s_nop 0
    v_permlane32_swap_b32 v220, v236
    v_permlane32_swap_b32 v222, v237
    v_add_f32 v220, v220, v236
    v_add_f32 v222, v222, v237
    v_add_f32 v220, v220, v246
    v_add_f32 v222, v222, v247
    v_cvt_pk_bf16_f32 v220, v220, v222
    s_mov_b64 exec, 3
    buffer_store_dword v220, v19, s[56:59], 0 offen
    s_or_b32 s30, s28, s27
    s_cmp_eq_u32 s30, 0
    s_cbranch_scc0 L_main_fin
    s_mov_b64 exec, 1
    v_mov_b32 v244, 0
    v_mov_b32 v245, s29
    buffer_store_dword v245, v244, s[48:51], 0 offen
L_main_fin:
    s_endpgm
L_aux:
    s_cmp_eq_u32 s26, 6
    s_cbranch_scc1 L_gath
    v_lshlrev_b32 v57, 4, v1
    s_cmp_eq_u32 s26, 5
    s_cbranch_scc1 L_w1_addr
    v_lshlrev_b32 v6, 17, v3
    v_lshl_add_u32 v6, v2, 4, v6
    s_lshl_b32 s30, s28, 19
    s_lshl_b32 s31, s27, 8
    s_add_u32 s86, s30, s31
    s_waitcnt lgkmcnt(0)
    s_mov_b32 s52, s4
    s_mov_b32 s53, s5
    s_mov_b32 s54, 1024
    s_mov_b32 s55, 0x20000
    buffer_load_dwordx4 v[8:11], v57, s[52:55], 0 offen
    s_add_u32 s32, s10, s86
    s_addc_u32 s33, s11, 0
    s_mov_b32 s34, 516352
    s_mov_b32 s35, 0x20000
    s_mov_b32 s62, 0
    buffer_load_dwordx4 v[64:67], v6, s[32:35], s62 offen nt
    s_add_u32 s62, s62, 8192
    buffer_load_dwordx4 v[68:71], v6, s[32:35], s62 offen nt
    s_add_u32 s62, s62, 8192
    buffer_load_dwordx4 v[72:75], v6, s[32:35], s62 offen nt
    s_add_u32 s62, s62, 8192
    buffer_load_dwordx4 v[76:79], v6, s[32:35], s62 offen nt
    s_add_u32 s62, s62, 8192
    buffer_load_dwordx4 v[80:83], v6, s[32:35], s62 offen nt
    s_add_u32 s62, s62, 8192
    buffer_load_dwordx4 v[84:87], v6, s[32:35], s62 offen nt
    s_add_u32 s62, s62, 8192
    buffer_load_dwordx4 v[88:91], v6, s[32:35], s62 offen nt
    s_add_u32 s62, s62, 8192
    buffer_load_dwordx4 v[92:95], v6, s[32:35], s62 offen nt
    s_add_u32 s62, s62, 8192
    buffer_load_dwordx4 v[96:99], v6, s[32:35], s62 offen nt
    s_add_u32 s62, s62, 8192
    buffer_load_dwordx4 v[100:103], v6, s[32:35], s62 offen nt
    s_add_u32 s62, s62, 8192
    buffer_load_dwordx4 v[104:107], v6, s[32:35], s62 offen nt
    s_add_u32 s62, s62, 8192
    buffer_load_dwordx4 v[108:111], v6, s[32:35], s62 offen nt
    s_add_u32 s62, s62, 8192
    buffer_load_dwordx4 v[112:115], v6, s[32:35], s62 offen nt
    s_add_u32 s62, s62, 8192
    buffer_load_dwordx4 v[116:119], v6, s[32:35], s62 offen nt
    s_add_u32 s62, s62, 8192
    buffer_load_dwordx4 v[120:123], v6, s[32:35], s62 offen nt
    s_add_u32 s62, s62, 8192
    buffer_load_dwordx4 v[124:127], v6, s[32:35], s62 offen nt
    s_branch L_aux_ld
L_w1_addr:
    s_and_b32 s30, s2, 7
    s_lshr_b32 s31, s2, 3
    s_mul_i32 s30, s30, 22
    s_add_u32 s30, s30, s31
    s_lshr_b32 s81, s30, 3
    s_and_b32 s82, s30, 7
    s_cmp_lt_u32 s31, 22
    s_cselect_b32 s83, 1, 0
    v_mul_u32_u24 v6, 22016, v5
    v_lshl_add_u32 v6, v4, 4, v6
    s_cmp_eq_u32 s81, 21
    s_cselect_b32 s30, 4, 8
    v_cmp_le_u32 vcc, s30, v4
    v_mov_b32 v58, 268435456
    s_nop 0
    v_cndmask_b32 v6, v6, v58, vcc
    s_mul_i32 s30, s82, 176128
    s_lshl_b32 s31, s81, 7
    s_add_u32 s86, s30, s31
    s_waitcnt lgkmcnt(0)
    s_mov_b32 s52, s4
    s_mov_b32 s53, s5
    s_mov_b32 s54, 1024
    s_mov_b32 s55, 0x20000
    buffer_load_dwordx4 v[8:11], v57, s[52:55], 0 offen
    s_add_u32 s32, s16, s86
    s_addc_u32 s33, s17, 0
    s_sub_u32 s30, 1409024, s86
    s_cmp_eq_u32 s83, 1
    s_cselect_b32 s34, s30, 0
    s_mov_b32 s35, 0x20000
    s_mov_b32 s62, 0
    buffer_load_dwordx4 v[64:67], v6, s[32:35], s62 offen nt
    s_add_u32 s62, s62, 2752
    buffer_load_dwordx4 v[68:71], v6, s[32:35], s62 offen nt
    s_add_u32 s62, s62, 2752
    buffer_load_dwordx4 v[72:75], v6, s[32:35], s62 offen nt
    s_add_u32 s62, s62, 2752
    buffer_load_dwordx4 v[76:79], v6, s[32:35], s62 offen nt
    s_add_u32 s62, s62, 2752
    buffer_load_dwordx4 v[80:83], v6, s[32:35], s62 offen nt
    s_add_u32 s62, s62, 2752
    buffer_load_dwordx4 v[84:87], v6, s[32:35], s62 offen nt
    s_add_u32 s62, s62, 2752
    buffer_load_dwordx4 v[88:91], v6, s[32:35], s62 offen nt
    s_add_u32 s62, s62, 2752
    buffer_load_dwordx4 v[92:95], v6, s[32:35], s62 offen nt
L_aux_ld:
    s_barrier
    s_mov_b32 s48, s24
    s_mov_b32 s49, s25
    s_mov_b32 s50, 1507328
    s_mov_b32 s51, 0x20000
    v_mov_b32 v58, 0x0c0c0100
    v_mov_b32 v59, 0x01000c0c
    s_mov_b32 s84, 0xaaaaaaaa
    s_mov_b32 s85, 0xaaaaaaaa
    v_cndmask_b32 v20, v58, v59, s[84:85]
    v_mov_b32 v58, 0x0c0c0302
    v_mov_b32 v59, 0x03020c0c
    v_cndmask_b32 v21, v58, v59, s[84:85]
    v_mov_b32 v58, 0x0c0c0c0c
    s_mov_b32 s84, 0x3030303
    s_mov_b32 s85, 0x3030303
    v_cndmask_b32 v28, v58, v20, s[84:85]
    v_cndmask_b32 v29, v58, v21, s[84:85]
    s_mov_b32 s84, 0xc0c0c0c
    s_mov_b32 s85, 0xc0c0c0c
    v_cndmask_b32 v30, v58, v20, s[84:85]
    v_cndmask_b32 v31, v58, v21, s[84:85]
    s_mov_b32 s84, 0x30303030
    s_mov_b32 s85, 0x30303030
    v_cndmask_b32 v32, v58, v20, s[84:85]
    v_cndmask_b32 v33, v58, v21, s[84:85]
    s_mov_b32 s84, 0xc0c0c0c0
    s_mov_b32 s85, 0xc0c0c0c0
    v_cndmask_b32 v34, v58, v20, s[84:85]
    v_cndmask_b32 v35, v58, v21, s[84:85]
    s_cmp_eq_u32 s26, 5
    s_cbranch_scc1 Lx_9
    s_waitcnt vmcnt(16)
    s_branch Lx_10
Lx_9:
    s_waitcnt vmcnt(8)
Lx_10:
    v_lshlrev_b32 v12, 16, v8
    v_and_b32 v13, 0xffff0000, v8
    v_lshlrev_b32 v14, 16, v9
    v_and_b32 v15, 0xffff0000, v9
    v_lshlrev_b32 v16, 16, v10
    v_and_b32 v17, 0xffff0000, v10
    v_lshlrev_b32 v18, 16, v11
    v_and_b32 v19, 0xffff0000, v11
    v_add_f32 v57, v12, v13
    v_add_f32 v58, v14, v15
    v_add_f32 v59, v16, v17
    v_add_f32 v128, v18, v19
    v_add_f32 v57, v57, v58
    v_add_f32 v59, v59, v128
    v_add_f32 v57, v57, v59
    s_nop 1
    v_add_f32_dpp v57, v57, v57 quad_perm:[1,0,3,2] row_mask:0xf bank_mask:0xf
    s_nop 1
    v_add_f32_dpp v57, v57, v57 quad_perm:[2,3,0,1] row_mask:0xf bank_mask:0xf
    s_nop 1
    v_add_f32_dpp v57, v57, v57 row_half_mirror row_mask:0xf bank_mask:0xf
    s_nop 1
    v_add_f32_dpp v57, v57, v57 row_mirror row_mask:0xf bank_mask:0xf
    s_nop 1
    v_add_f32_dpp v57, v57, v57 row_bcast:15 row_mask:0xa bank_mask:0xf
    s_nop 1
    v_add_f32_dpp v57, v57, v57 row_bcast:31 row_mask:0xc bank_mask:0xf
    s_nop 0
    v_readlane_b32 s30, v57, 63
    v_mov_b32 v58, 0x3b000000
    s_nop 0
    v_mul_f32 v129, s30, v58
    v_sub_f32 v20, v12, v129
    v_sub_f32 v21, v13, v129
    v_sub_f32 v22, v14, v129
    v_sub_f32 v23, v15, v129
    v_sub_f32 v24, v16, v129
    v_sub_f32 v25, v17, v129
    v_sub_f32 v26, v18, v129
    v_sub_f32 v27, v19, v129
    v_mul_f32 v57, v20, v20
    v_mul_f32 v59, v21, v21
    v_fmac_f32 v57, v22, v22
    v_fmac_f32 v59, v23, v23
    v_fmac_f32 v57, v24, v24
    v_fmac_f32 v59, v25, v25
    v_fmac_f32 v57, v26, v26
    v_fmac_f32 v59, v27, v27
    v_add_f32 v57, v57, v59
    v_cvt_pk_bf16_f32 v129, v129, v129
    v_and_b32 v129, 0xffff0000, v129
    v_sub_f32 v12, v12, v129
    v_sub_f32 v13, v13, v129
    v_sub_f32 v14, v14, v129
    v_sub_f32 v15, v15, v129
    v_sub_f32 v16, v16, v129
    v_sub_f32 v17, v17, v129
    v_sub_f32 v18, v18, v129
    v_sub_f32 v19, v19, v129
    v_add_f32_dpp v57, v57, v57 quad_perm:[1,0,3,2] row_mask:0xf bank_mask:0xf
    s_nop 1
    v_add_f32_dpp v57, v57, v57 quad_perm:[2,3,0,1] row_mask:0xf bank_mask:0xf
    s_nop 1
    v_add_f32_dpp v57, v57, v57 row_half_mirror row_mask:0xf bank_mask:0xf
    s_nop 1
    v_add_f32_dpp v57, v57, v57 row_mirror row_mask:0xf bank_mask:0xf
    s_nop 1
    v_add_f32_dpp v57, v57, v57 row_bcast:15 row_mask:0xa bank_mask:0xf
    s_nop 1
    v_add_f32_dpp v57, v57, v57 row_bcast:31 row_mask:0xc bank_mask:0xf
    s_nop 0
    v_readlane_b32 s30, v57, 63
    v_cvt_pk_bf16_f32 v20, v12, v13
    v_cvt_pk_bf16_f32 v21, v14, v15
    v_cvt_pk_bf16_f32 v22, v16, v17
    v_cvt_pk_bf16_f32 v23, v18, v19
    v_mul_f32 v57, s30, v58
    v_lshlrev_b32 v12, 16, v20
    v_and_b32 v13, 0xffff0000, v20
    v_lshlrev_b32 v14, 16, v21
    v_and_b32 v15, 0xffff0000, v21
    v_lshlrev_b32 v16, 16, v22
    v_and_b32 v17, 0xffff0000, v22
    v_lshlrev_b32 v18, 16, v23
    v_and_b32 v19, 0xffff0000, v23
    v_cvt_pk_bf16_f32 v57, v57, v57
    v_and_b32 v57, 0xffff0000, v57
    v_add_f32 v57, 0x3727c5ac, v57
    v_cvt_pk_bf16_f32 v57, v57, v57
    v_and_b32 v57, 0xffff0000, v57
    v_sqrt_f32 v130, v57
    s_nop 0
    v_cvt_pk_bf16_f32 v130, v130, v130
    v_and_b32 v130, 0xffff0000, v130
    v_rcp_f32 v131, v130
    s_nop 0
    v_mul_f32 v12, v12, v131
    v_mul_f32 v13, v13, v131
    v_mul_f32 v14, v14, v131
    v_mul_f32 v15, v15, v131
    v_mul_f32 v16, v16, v131
    v_mul_f32 v17, v17, v131
    v_mul_f32 v18, v18, v131
    v_mul_f32 v19, v19, v131
    v_cvt_pk_bf16_f32 v8, v12, v13
    v_cvt_pk_bf16_f32 v9, v14, v15
    v_cvt_pk_bf16_f32 v10, v16, v17
    v_cvt_pk_bf16_f32 v11, v18, v19
    s_sub_u32 s30, s26, 4
    s_lshl_b32 s30, s30, 10
    v_lshlrev_b32 v57, 4, v1
    v_add_u32 v57, s30, v57
    ds_write_b128 v57, v[8:11] offset:8192
    s_cmp_eq_u32 s26, 5
    s_cbranch_scc1 L_prod_w1
    s_lshl_b32 s30, s28, 7
    v_lshlrev_b32 v58, 5, v3
    v_add_u32 v58, s30, v58
    ds_read_b128 v[36:39], v58 offset:8192
    ds_read_b128 v[40:43], v58 offset:8208
    v_lshrrev_b32 v7, 4, v1
    v_lshlrev_b32 v7, 6, v7
    v_and_b32 v59, 3, v1
    v_lshl_add_u32 v7, v59, 3, v7
    v_bfe_u32 v59, v1, 2, 2
    v_add_lshl_u32 v7, v7, v59, 2
    s_lshl_b32 s30, s27, 3
    s_add_u32 s30, s30, s28
    s_lshl_b32 s30, s30, 10
    s_add_u32 s30, s30, 4096
    v_lshlrev_b32 v56, 4, v1
    v_add_u32 v56, s30, v56
    s_waitcnt lgkmcnt(0)
    s_load_dword s29, s[24:25], 0
    v_perm_b32 v44, v36, v36, v28
    v_perm_b32 v45, v36, v36, v30
    v_perm_b32 v46, v36, v36, v32
    v_perm_b32 v47, v36, v36, v34
    v_perm_b32 v48, v36, v36, v29
    v_perm_b32 v49, v36, v36, v31
    v_perm_b32 v50, v36, v36, v33
    v_perm_b32 v51, v36, v36, v35
    s_waitcnt vmcnt(15)
    v_mfma_f32_16x16x32_bf16 v[52:55], v[64:67], v[44:47], 0
    v_perm_b32 v44, v37, v37, v28
    v_perm_b32 v45, v37, v37, v30
    v_perm_b32 v46, v37, v37, v32
    v_perm_b32 v47, v37, v37, v34
    s_waitcnt vmcnt(14)
    v_mfma_f32_16x16x32_bf16 v[52:55], v[68:71], v[48:51], v[52:55]
    v_perm_b32 v48, v37, v37, v29
    v_perm_b32 v49, v37, v37, v31
    v_perm_b32 v50, v37, v37, v33
    v_perm_b32 v51, v37, v37, v35
    s_waitcnt vmcnt(13)
    v_mfma_f32_16x16x32_bf16 v[52:55], v[72:75], v[44:47], v[52:55]
    v_perm_b32 v44, v38, v38, v28
    v_perm_b32 v45, v38, v38, v30
    v_perm_b32 v46, v38, v38, v32
    v_perm_b32 v47, v38, v38, v34
    s_waitcnt vmcnt(12)
    v_mfma_f32_16x16x32_bf16 v[52:55], v[76:79], v[48:51], v[52:55]
    v_perm_b32 v48, v38, v38, v29
    v_perm_b32 v49, v38, v38, v31
    v_perm_b32 v50, v38, v38, v33
    v_perm_b32 v51, v38, v38, v35
    s_waitcnt vmcnt(11)
    v_mfma_f32_16x16x32_bf16 v[52:55], v[80:83], v[44:47], v[52:55]
    v_perm_b32 v44, v39, v39, v28
    v_perm_b32 v45, v39, v39, v30
    v_perm_b32 v46, v39, v39, v32
    v_perm_b32 v47, v39, v39, v34
    s_waitcnt vmcnt(10)
    v_mfma_f32_16x16x32_bf16 v[52:55], v[84:87], v[48:51], v[52:55]
    v_perm_b32 v48, v39, v39, v29
    v_perm_b32 v49, v39, v39, v31
    v_perm_b32 v50, v39, v39, v33
    v_perm_b32 v51, v39, v39, v35
    s_waitcnt vmcnt(9)
    v_mfma_f32_16x16x32_bf16 v[52:55], v[88:91], v[44:47], v[52:55]
    v_perm_b32 v44, v40, v40, v28
    v_perm_b32 v45, v40, v40, v30
    v_perm_b32 v46, v40, v40, v32
    v_perm_b32 v47, v40, v40, v34
    s_waitcnt vmcnt(8)
    v_mfma_f32_16x16x32_bf16 v[52:55], v[92:95], v[48:51], v[52:55]
    v_perm_b32 v48, v40, v40, v29
    v_perm_b32 v49, v40, v40, v31
    v_perm_b32 v50, v40, v40, v33
    v_perm_b32 v51, v40, v40, v35
    s_waitcnt vmcnt(7)
    v_mfma_f32_16x16x32_bf16 v[52:55], v[96:99], v[44:47], v[52:55]
    v_perm_b32 v44, v41, v41, v28
    v_perm_b32 v45, v41, v41, v30
    v_perm_b32 v46, v41, v41, v32
    v_perm_b32 v47, v41, v41, v34
    s_waitcnt vmcnt(6)
    v_mfma_f32_16x16x32_bf16 v[52:55], v[100:103], v[48:51], v[52:55]
    v_perm_b32 v48, v41, v41, v29
    v_perm_b32 v49, v41, v41, v31
    v_perm_b32 v50, v41, v41, v33
    v_perm_b32 v51, v41, v41, v35
    s_waitcnt vmcnt(5)
    v_mfma_f32_16x16x32_bf16 v[52:55], v[104:107], v[44:47], v[52:55]
    v_perm_b32 v44, v42, v42, v28
    v_perm_b32 v45, v42, v42, v30
    v_perm_b32 v46, v42, v42, v32
    v_perm_b32 v47, v42, v42, v34
    s_waitcnt vmcnt(4)
    v_mfma_f32_16x16x32_bf16 v[52:55], v[108:111], v[48:51], v[52:55]
    v_perm_b32 v48, v42, v42, v29
    v_perm_b32 v49, v42, v42, v31
    v_perm_b32 v50, v42, v42, v33
    v_perm_b32 v51, v42, v42, v35
    s_waitcnt vmcnt(3)
    v_mfma_f32_16x16x32_bf16 v[52:55], v[112:115], v[44:47], v[52:55]
    v_perm_b32 v44, v43, v43, v28
    v_perm_b32 v45, v43, v43, v30
    v_perm_b32 v46, v43, v43, v32
    v_perm_b32 v47, v43, v43, v34
    s_waitcnt vmcnt(2)
    v_mfma_f32_16x16x32_bf16 v[52:55], v[116:119], v[48:51], v[52:55]
    v_perm_b32 v48, v43, v43, v29
    v_perm_b32 v49, v43, v43, v31
    v_perm_b32 v50, v43, v43, v33
    v_perm_b32 v51, v43, v43, v35
    s_waitcnt vmcnt(1)
    v_mfma_f32_16x16x32_bf16 v[52:55], v[120:123], v[44:47], v[52:55]
    s_waitcnt vmcnt(0)
    v_mfma_f32_16x16x32_bf16 v[52:55], v[124:127], v[48:51], v[52:55]
    s_getreg_b32 s87, hwreg(HW_REG_XCC_ID, 0, 4)
    s_waitcnt lgkmcnt(0)
    s_add_u32 s29, s29, 0x9e3779b9
    s_and_b32 s61, s29, 0xfffffff0
    s_or_b32 s87, s87, s61
    v_lshlrev_b32 v57, 4, v1
    v_mov_b32 v61, s87
    v_mov_b32 v63, s87
    ds_write_b128 v57, v[52:55] offset:10240
    ds_read_b32 v60, v7 offset:10240
    ds_read_b32 v62, v7 offset:10256
    s_waitcnt lgkmcnt(0)
    s_mov_b32 s77, 0x120000
    buffer_store_dwordx4 v[60:63], v56, s[48:51], s77 offen
    buffer_store_dwordx4 v[60:63], v56, s[48:51], 0 offen sc1
    s_branch L_prod_done
L_prod_w1:
    s_lshl_b32 s30, s82, 7
    v_lshlrev_b32 v58, 4, v5
    v_add_u32 v58, s30, v58
    ds_read_b128 v[36:39], v58 offset:9216
    v_lshrrev_b32 v7, 5, v1
    v_lshlrev_b32 v7, 6, v7
    v_and_b32 v59, 7, v1
    v_lshl_add_u32 v7, v59, 2, v7
    v_bfe_u32 v59, v1, 3, 2
    v_add_lshl_u32 v7, v7, v59, 2
    s_mul_i32 s30, s82, 11264
    s_lshl_b32 s31, s81, 9
    s_add_u32 s30, s30, s31
    s_add_u32 s30, s30, 270336
    s_cmp_eq_u32 s83, 1
    s_cselect_b32 s30, s30, 268435456
    v_lshlrev_b32 v56, 3, v1
    v_add_u32 v56, s30, v56
    s_waitcnt lgkmcnt(0)
    s_load_dword s29, s[24:25], 0
    v_perm_b32 v44, v36, v36, v28
    v_perm_b32 v45, v36, v36, v30
    v_perm_b32 v46, v36, v36, v32
    v_perm_b32 v47, v36, v36, v34
    v_perm_b32 v48, v36, v36, v29
    v_perm_b32 v49, v36, v36, v31
    v_perm_b32 v50, v36, v36, v33
    v_perm_b32 v51, v36, v36, v35
    s_waitcnt vmcnt(7)
    v_mfma_f32_16x16x32_bf16 v[52:55], v[64:67], v[44:47], 0
    v_perm_b32 v44, v37, v37, v28
    v_perm_b32 v45, v37, v37, v30
    v_perm_b32 v46, v37, v37, v32
    v_perm_b32 v47, v37, v37, v34
    s_waitcnt vmcnt(6)
    v_mfma_f32_16x16x32_bf16 v[52:55], v[68:71], v[48:51], v[52:55]
    v_perm_b32 v48, v37, v37, v29
    v_perm_b32 v49, v37, v37, v31
    v_perm_b32 v50, v37, v37, v33
    v_perm_b32 v51, v37, v37, v35
    s_waitcnt vmcnt(5)
    v_mfma_f32_16x16x32_bf16 v[52:55], v[72:75], v[44:47], v[52:55]
    v_perm_b32 v44, v38, v38, v28
    v_perm_b32 v45, v38, v38, v30
    v_perm_b32 v46, v38, v38, v32
    v_perm_b32 v47, v38, v38, v34
    s_waitcnt vmcnt(4)
    v_mfma_f32_16x16x32_bf16 v[52:55], v[76:79], v[48:51], v[52:55]
    v_perm_b32 v48, v38, v38, v29
    v_perm_b32 v49, v38, v38, v31
    v_perm_b32 v50, v38, v38, v33
    v_perm_b32 v51, v38, v38, v35
    s_waitcnt vmcnt(3)
    v_mfma_f32_16x16x32_bf16 v[52:55], v[80:83], v[44:47], v[52:55]
    v_perm_b32 v44, v39, v39, v28
    v_perm_b32 v45, v39, v39, v30
    v_perm_b32 v46, v39, v39, v32
    v_perm_b32 v47, v39, v39, v34
    s_waitcnt vmcnt(2)
    v_mfma_f32_16x16x32_bf16 v[52:55], v[84:87], v[48:51], v[52:55]
    v_perm_b32 v48, v39, v39, v29
    v_perm_b32 v49, v39, v39, v31
    v_perm_b32 v50, v39, v39, v33
    v_perm_b32 v51, v39, v39, v35
    s_waitcnt vmcnt(1)
    v_mfma_f32_16x16x32_bf16 v[52:55], v[88:91], v[44:47], v[52:55]
    s_waitcnt vmcnt(0)
    v_mfma_f32_16x16x32_bf16 v[52:55], v[92:95], v[48:51], v[52:55]
    s_waitcnt lgkmcnt(0)
    s_add_u32 s29, s29, 0x9e3779b9
    v_lshlrev_b32 v57, 4, v1
    v_mov_b32 v61, s29
    s_nop 3
    ds_write_b128 v57, v[52:55] offset:11264
    ds_read_b32 v60, v7 offset:11264
    ds_read_b32 v62, v7 offset:11904
    s_waitcnt lgkmcnt(0)
    v_add_f32 v60, v60, v62
    buffer_store_dwordx2 v[60:61], v56, s[48:51], 0 offen sc1
L_prod_done:
    s_sub_u32 s30, s26, 4
    s_lshl_b32 s30, s30, 6
    v_add_u32 v57, s30, v1
    v_lshrrev_b32 v7, 5, v57
    v_lshlrev_b32 v7, 6, v7
    v_and_b32 v59, 7, v57
    v_lshl_add_u32 v7, v59, 2, v7
    v_bfe_u32 v59, v57, 3, 2
    v_add_lshl_u32 v7, v7, v59, 2
    s_lshl_b32 s30, s27, 3
    s_add_u32 s30, s30, s28
    s_lshl_b32 s30, s30, 10
    s_add_u32 s30, s30, 393216
    v_lshlrev_b32 v56, 3, v57
    v_add_u32 v56, s30, v56
    v_mov_b32 v61, s29
    s_mov_b32 s91, 458752
    s_waitcnt lgkmcnt(0)
    s_barrier
    s_barrier
    s_barrier
    ds_read2st64_b32 v[12:13], v7 offset0:0 offset1:4
    ds_read2st64_b32 v[14:15], v7 offset0:8 offset1:12
    s_waitcnt lgkmcnt(0)
    v_add_f32 v12, v12, v13
    v_add_f32 v14, v14, v15
    v_add_f32 v60, v12, v14
    buffer_store_dwordx2 v[60:61], v56, s[48:51], s91 offen
    buffer_store_dwordx2 v[60:61], v56, s[48:51], 0 offen sc1
    s_cmp_eq_u32 s26, 5
    s_cbranch_scc0 L_ypub
    s_barrier
    s_branch L_aux_fin
L_ypub:
    v_lshrrev_b32 v7, 5, v1
    v_lshlrev_b32 v7, 6, v7
    v_and_b32 v59, 7, v1
    v_lshl_add_u32 v7, v59, 2, v7
    v_bfe_u32 v59, v1, 3, 2
    v_add_lshl_u32 v7, v7, v59, 2
    v_add_u32 v57, 640, v7
    s_lshl_b32 s30, s28, 5
    s_add_u32 s30, s30, s27
    s_lshl_b32 s30, s30, 9
    s_add_u32 s30, s30, 720896
    v_lshlrev_b32 v56, 3, v1
    v_add_u32 v56, s30, v56
    s_barrier
    ds_read2st64_b32 v[12:13], v7 offset0:16 offset1:20
    ds_read2st64_b32 v[14:15], v7 offset0:24 offset1:28
    ds_read2st64_b32 v[16:17], v57 offset0:16 offset1:20
    ds_read2st64_b32 v[18:19], v57 offset0:24 offset1:28
    s_waitcnt lgkmcnt(0)
    v_add_f32 v12, v12, v13
    v_add_f32 v14, v14, v15
    v_add_f32 v16, v16, v17
    v_add_f32 v18, v18, v19
    v_add_f32 v12, v12, v14
    v_add_f32 v16, v16, v18
    v_add_f32 v60, v12, v16
    buffer_store_dwordx2 v[60:61], v56, s[48:51], 0 offen sc1
L_aux_fin:
    s_endpgm
L_gath:
    s_lshl_b32 s30, s27, 13
    s_add_u32 s30, s30, 4096
    v_lshlrev_b32 v6, 10, v4
    v_lshl_add_u32 v6, v5, 7, v6
    v_add_u32 v6, s30, v6
    v_mov_b32 v28, 0
    v_mov_b32 v29, 0
    v_mov_b32 v30, 0
    v_mov_b32 v31, 0
    ds_write_b128 v28, v[28:31] offset:12544
    s_waitcnt lgkmcnt(0)
    s_load_dword s29, s[24:25], 0
    s_lshl_b32 s30, s27, 21
    s_add_u32 s30, s30, 0x180000
    s_add_u32 s40, s8, s30
    s_addc_u32 s41, s9, 0
    s_load_dword s44, s[40:41], 0
    s_lshl_b32 s30, s27, 17
    s_add_u32 s42, s12, s30
    s_addc_u32 s43, s13, 0
    s_load_dword s45, s[42:43], 0
    s_mul_i32 s30, s27, 44032
    s_add_u32 s36, s18, s30
    s_addc_u32 s37, s19, 0
    s_load_dword s46, s[36:37], 0
    s_mov_b32 s48, s24
    s_mov_b32 s49, s25
    s_mov_b32 s50, 1507328
    s_mov_b32 s51, 0x20000
    s_barrier
    s_getreg_b32 s87, hwreg(HW_REG_XCC_ID, 0, 4)
    s_waitcnt lgkmcnt(0)
    s_add_u32 s29, s29, 0x9e3779b9
    s_and_b32 s61, s29, 0xfffffff0
    s_or_b32 s87, s87, s61
    s_lshl_b32 s30, s27, 3
    s_add_u32 s30, s30, s28
    s_lshl_b32 s30, s30, 10
    v_lshlrev_b32 v40, 4, v1
    v_add_u32 v40, s30, v40
    s_lshl_b32 s30, s28, 5
    s_add_u32 s30, s30, s27
    s_lshl_b32 s30, s30, 9
    s_add_u32 s30, s30, 720896
    v_lshlrev_b32 v41, 3, v1
    v_add_u32 v41, s30, v41
    buffer_load_dwordx2 v[52:53], v41, s[48:51], 0 offen sc1
    s_lshl_b32 s30, s27, 7
    s_lshl_b32 s31, s28, 4
    s_add_u32 s30, s30, s31
    s_add_u32 s30, s30, 655360
    v_lshlrev_b32 v34, 3, v1
    v_add_u32 v34, s30, v34
    v_cmp_gt_u32 vcc, 2, v1
    v_mov_b32 v35, 268435456
    s_nop 0
    v_cndmask_b32 v34, v35, v34, vcc
    v_mov_b32 v37, s29
    s_mov_b32 s77, 0x120000
    s_mov_b32 s91, 458752
    s_waitcnt vmcnt(0) lgkmcnt(0)
    s_barrier
    s_barrier
    s_barrier
    ds_read_b128 v[40:43], v28 offset:12672
    ds_read_b128 v[44:47], v28 offset:12688
    ds_read_b128 v[48:51], v28 offset:12704
    ds_read_b128 v[52:55], v28 offset:12720
    ds_read_b32 v38, v28 offset:12564
    v_cmp_eq_u32 vcc, 0, v1
    s_waitcnt lgkmcnt(0)
    v_add_f32 v40, v40, v41
    v_add_f32 v42, v42, v43
    v_add_f32 v44, v44, v45
    v_add_f32 v46, v46, v47
    v_add_f32 v48, v48, v49
    v_add_f32 v50, v50, v51
    v_add_f32 v52, v52, v53
    v_add_f32 v54, v54, v55
    v_add_f32 v40, v40, v42
    v_add_f32 v44, v44, v46
    v_add_f32 v48, v48, v50
    v_add_f32 v52, v52, v54
    v_add_f32 v40, v40, v44
    v_add_f32 v48, v48, v52
    v_add_f32 v40, v40, v48
    v_cndmask_b32 v36, v40, v38, vcc
    buffer_store_dwordx2 v[36:37], v34, s[48:51], s91 offen
    buffer_store_dwordx2 v[36:37], v34, s[48:51], 0 offen sc1
    s_barrier
L_end:
    s_endpgm

.section .rodata,"a"
.p2align 6
.amdhsa_kernel parallel_sum__sliding_block_cached__dense_activation_silu__decode_kernel
  .amdhsa_next_free_vgpr 256
  .amdhsa_next_free_sgpr 102
  .amdhsa_accum_offset 256
  .amdhsa_group_segment_fixed_size 0
  .amdhsa_kernarg_size 88
  .amdhsa_user_sgpr_count 2
  .amdhsa_user_sgpr_kernarg_segment_ptr 1
  .amdhsa_system_sgpr_workgroup_id_x 1
.end_amdhsa_kernel
```
